```python
import torch

def _softmax(x, axis=-1):
    return torch.softmax(x, dim=axis)
def _gelu(x):
    return torch.nn.functional.gelu(x, approximate="tanh")
def _silu(x):
    return torch.nn.functional.silu(x)
def _sigmoid(x):
    return torch.sigmoid(x)
def _layernorm(x, axis=-1, eps=1e-5):
    m = x.mean(dim=axis, keepdim=True)
    v = x.var(dim=axis, keepdim=True, unbiased=False)
    return (x - m) / torch.sqrt(v + eps)
def _scatter_add(tgt, idx, src, axis=0):
    return tgt.clone().index_add_(axis, idx, src)
def _segment_sum(src, seg, n):
    out = torch.zeros((n,) + src.shape[1:], dtype=src.dtype)
    return out.index_add_(0, seg, src)
def _pad(x, pw):
    flat = tuple(v for pair in reversed(pw) for v in pair)
    return torch.nn.functional.pad(x, flat)

kernel_name = 'standalone__gqa_softmax__sampling'

def setup_inputs():

    _w = (lambda a: (lambda t: t.to(torch.bfloat16) if t.is_floating_point() else t)(torch.as_tensor(a)))
    B, Hq, Hkv, Sq, Sk, D = 32, 32, 8, 8, 2048, 128
    return {
        "q": _w((lambda *s: torch.randn(*s, dtype=torch.bfloat16) * 0.8)(B, Hq, Sq, D)),
        "k": _w((lambda *s: torch.randn(*s, dtype=torch.bfloat16) * 0.8)(B, Hkv, Sk, D)),
        "v": _w((lambda *s: torch.randn(*s, dtype=torch.bfloat16) * 0.05)(B, Hkv, Sk, D)),
    }

def reference(q, k, v):
    B, Hq, Sq, D = q.shape
    Hkv = k.shape[1]
    rep = Hq // Hkv
    k = (lambda x, n, axis: torch.repeat_interleave(x, n, dim=axis))(k, rep, axis=1)
    v = (lambda x, n, axis: torch.repeat_interleave(x, n, dim=axis))(v, rep, axis=1)
    scale = D ** -0.5
    scores = torch.einsum("bhqd,bhkd->bhqk", q, k) * scale
    p = _softmax(scores, axis=-1)
    return torch.einsum("bhqk,bhkd->bhqd", p, v)
```

```asm
; @launch grid=(256,1,1) block=(320,1,1) lds=139520
.amdgcn_target "amdgcn-amd-amdhsa--gfx950"
.text
.globl standalone__gqa_softmax__sampling_kernel
.p2align 8
.type standalone__gqa_softmax__sampling_kernel,@function
standalone__gqa_softmax__sampling_kernel:
    s_load_dwordx8 s[4:11], s[0:1], 0
    s_load_dwordx2 s[58:59], s[0:1], 32
    v_lshrrev_b32 v1, 6, v0
    v_and_b32 v2, 15, v0
    v_readfirstlane_b32 s28, v1
    v_bfe_u32 v3, v0, 4, 2
    s_cmp_ge_u32 s2, 256
    s_cbranch_scc1 L_end
    v_xor_b32 v4, v2, v3
    s_cmp_lg_u32 s28, 0
    s_cbranch_scc1 L_consumer
    v_bfe_u32 v5, v0, 4, 1
    v_bfe_u32 v6, v0, 5, 1
    v_mul_u32_u24 v5, 8192, v5
    v_mul_u32_u24 v6, 70144, v6
    v_xor_b32 v5, v5, v6
    s_bitcmp1_b32 s2, 0
    s_cselect_b32 s60, 2048, 0
    s_bitcmp1_b32 s2, 1
    s_cselect_b32 s61, 131072, 0
    s_xor_b32 s60, s60, s61
    v_lshl_add_u32 v8, v4, 4, v5
    s_lshl_b32 s36, s2, 19
    s_mov_b32 s14, 0x80000
    s_mov_b32 s15, 0x20000
    v_xor_b32 v9, 64, v8
    v_xor_b32 v10, 128, v8
    v_xor_b32 v11, 192, v8
    s_mov_b32 s31, 0
    s_mov_b32 s30, s60
    s_setprio 3
    s_waitcnt lgkmcnt(0)
    s_add_u32 s12, s6, s36
    s_addc_u32 s13, s7, 0
    s_mov_b64 vcc, -1
    v_mov_b32 v16, 139264
    s_mov_b32 m0, s31
    s_mov_b32 s33, s30
    v_xor_b32 v14, s33, v8
    buffer_load_dwordx4 v14, s[12:15], 0 offen nt lds
    s_add_u32 m0, s31, 1024
    s_xor_b32 s33, s30, 264704
    v_xor_b32 v14, s33, v9
    buffer_load_dwordx4 v14, s[12:15], 0 offen nt lds
    s_add_u32 m0, s31, 2048
    s_xor_b32 s33, s30, 33024
    v_xor_b32 v14, s33, v10
    buffer_load_dwordx4 v14, s[12:15], 0 offen nt lds
    s_add_u32 m0, s31, 3072
    s_xor_b32 s33, s30, 297728
    v_xor_b32 v14, s33, v11
    buffer_load_dwordx4 v14, s[12:15], 0 offen nt lds
    s_add_u32 m0, s31, 4096
    s_xor_b32 s33, s30, 16384
    v_xor_b32 v14, s33, v8
    buffer_load_dwordx4 v14, s[12:15], 0 offen nt lds
    s_add_u32 m0, s31, 5120
    s_xor_b32 s33, s30, 281088
    v_xor_b32 v14, s33, v9
    buffer_load_dwordx4 v14, s[12:15], 0 offen nt lds
    s_add_u32 m0, s31, 6144
    s_xor_b32 s33, s30, 49408
    v_xor_b32 v14, s33, v10
    buffer_load_dwordx4 v14, s[12:15], 0 offen nt lds
    s_add_u32 m0, s31, 7168
    s_xor_b32 s33, s30, 314112
    v_xor_b32 v14, s33, v11
    buffer_load_dwordx4 v14, s[12:15], 0 offen nt lds
    s_add_u32 m0, s31, 8192
    s_xor_b32 s33, s30, 4352
    v_xor_b32 v14, s33, v8
    buffer_load_dwordx4 v14, s[12:15], 0 offen nt lds
    s_add_u32 m0, s31, 9216
    s_xor_b32 s33, s30, 269056
    v_xor_b32 v14, s33, v9
    buffer_load_dwordx4 v14, s[12:15], 0 offen nt lds
    s_add_u32 m0, s31, 10240
    s_xor_b32 s33, s30, 36864
    v_xor_b32 v14, s33, v10
    buffer_load_dwordx4 v14, s[12:15], 0 offen nt lds
    s_add_u32 m0, s31, 11264
    s_xor_b32 s33, s30, 301568
    v_xor_b32 v14, s33, v11
    buffer_load_dwordx4 v14, s[12:15], 0 offen nt lds
    s_add_u32 m0, s31, 12288
    s_xor_b32 s33, s30, 20736
    v_xor_b32 v14, s33, v8
    buffer_load_dwordx4 v14, s[12:15], 0 offen nt lds
    s_add_u32 m0, s31, 13312
    s_xor_b32 s33, s30, 285440
    v_xor_b32 v14, s33, v9
    buffer_load_dwordx4 v14, s[12:15], 0 offen nt lds
    s_add_u32 m0, s31, 14336
    s_xor_b32 s33, s30, 53248
    v_xor_b32 v14, s33, v10
    buffer_load_dwordx4 v14, s[12:15], 0 offen nt lds
    s_add_u32 m0, s31, 15360
    s_xor_b32 s33, s30, 317952
    v_xor_b32 v14, s33, v11
    buffer_load_dwordx4 v14, s[12:15], 0 offen nt lds
    s_add_u32 m0, s31, 16384
    s_xor_b32 s33, s30, 37120
    v_xor_b32 v14, s33, v8
    buffer_load_dwordx4 v14, s[12:15], 0 offen nt lds
    s_add_u32 m0, s31, 17408
    s_xor_b32 s33, s30, 301824
    v_xor_b32 v14, s33, v9
    buffer_load_dwordx4 v14, s[12:15], 0 offen nt lds
    s_add_u32 m0, s31, 18432
    s_xor_b32 s33, s30, 4096
    v_xor_b32 v14, s33, v10
    buffer_load_dwordx4 v14, s[12:15], 0 offen nt lds
    s_add_u32 m0, s31, 19456
    s_xor_b32 s33, s30, 268800
    v_xor_b32 v14, s33, v11
    buffer_load_dwordx4 v14, s[12:15], 0 offen nt lds
    s_add_u32 m0, s31, 20480
    s_xor_b32 s33, s30, 53504
    v_xor_b32 v14, s33, v8
    buffer_load_dwordx4 v14, s[12:15], 0 offen nt lds
    s_cbranch_vccz L_p21
    s_waitcnt vmcnt(20)
L_p21:
    s_add_u32 m0, s31, 21504
    s_xor_b32 s33, s30, 318208
    v_xor_b32 v14, s33, v9
    buffer_load_dwordx4 v14, s[12:15], 0 offen nt lds
    s_cbranch_vccz L_p22
    s_waitcnt vmcnt(20)
L_p22:
    s_add_u32 m0, s31, 22528
    s_xor_b32 s33, s30, 20480
    v_xor_b32 v14, s33, v10
    buffer_load_dwordx4 v14, s[12:15], 0 offen nt lds
    s_add_u32 s16, s8, s36
    s_addc_u32 s17, s9, 0
    s_mov_b32 s18, 0x80000
    s_mov_b32 s19, 0x20000
    v_lshlrev_b32 v6, 1, v3
    v_xor_b32 v6, v2, v6
    v_lshl_add_u32 v12, v6, 4, v5
    v_xor_b32 v13, 128, v12
    s_mov_b32 s32, 0x10000
    s_mov_b32 s29, 0
    s_xor_b32 s37, s60, 264192
.p2align 6
L_ldloop:
    s_waitcnt vmcnt(22)
    s_cbranch_vccz L_w0
    s_waitcnt vmcnt(20)
L_w0:
    s_add_u32 m0, s31, 23552
    s_xor_b32 s33, s30, 285184
    v_xor_b32 v14, s33, v11
    buffer_load_dwordx4 v14, s[12:15], 0 offen nt lds
    s_waitcnt vmcnt(22)
    s_cbranch_vccz L_w1
    s_waitcnt vmcnt(20)
L_w1:
    s_add_u32 m0, s31, 24576
    s_xor_b32 s33, s30, 32768
    v_xor_b32 v14, s33, v8
    buffer_load_dwordx4 v14, s[12:15], 0 offen nt lds
    s_waitcnt vmcnt(22)
    s_cbranch_vccz L_w2
    s_waitcnt vmcnt(20)
L_w2:
    s_add_u32 m0, s31, 25600
    s_xor_b32 s33, s30, 297472
    v_xor_b32 v14, s33, v9
    buffer_load_dwordx4 v14, s[12:15], 0 offen nt lds
    s_waitcnt vmcnt(22)
    s_cbranch_vccz L_w3
    s_waitcnt vmcnt(20)
L_w3:
    s_add_u32 m0, s31, 26624
    s_xor_b32 s33, s30, 256
    v_xor_b32 v14, s33, v10
    buffer_load_dwordx4 v14, s[12:15], 0 offen nt lds
    s_waitcnt vmcnt(22)
    s_cbranch_vccz L_w4
    s_waitcnt vmcnt(20)
L_w4:
    s_add_u32 m0, s31, 27648
    s_xor_b32 s33, s30, 264960
    v_xor_b32 v14, s33, v11
    buffer_load_dwordx4 v14, s[12:15], 0 offen nt lds
    s_waitcnt vmcnt(22)
    s_cbranch_vccz L_w5
    s_waitcnt vmcnt(20)
L_w5:
    s_add_u32 m0, s31, 28672
    s_xor_b32 s33, s30, 49152
    v_xor_b32 v14, s33, v8
    buffer_load_dwordx4 v14, s[12:15], 0 offen nt lds
    s_waitcnt vmcnt(22)
    s_cbranch_vccz L_w6
    s_waitcnt vmcnt(20)
L_w6:
    s_add_u32 m0, s31, 29696
    s_xor_b32 s33, s30, 313856
    v_xor_b32 v14, s33, v9
    buffer_load_dwordx4 v14, s[12:15], 0 offen nt lds
    s_waitcnt vmcnt(22)
    s_cbranch_vccz L_w7
    s_waitcnt vmcnt(20)
L_w7:
    s_add_u32 m0, s31, 30720
    s_xor_b32 s33, s30, 16640
    v_xor_b32 v14, s33, v10
    buffer_load_dwordx4 v14, s[12:15], 0 offen nt lds
    s_waitcnt vmcnt(22)
    s_cbranch_vccz L_w8
    s_waitcnt vmcnt(20)
L_w8:
    s_add_u32 m0, s31, 31744
    s_xor_b32 s33, s30, 281344
    v_xor_b32 v14, s33, v11
    buffer_load_dwordx4 v14, s[12:15], 0 offen nt lds
    s_waitcnt vmcnt(22)
    s_cbranch_vccz L_w9
    s_waitcnt vmcnt(20)
L_w9:
    s_add_u32 m0, s31, 32768
    s_mov_b32 s33, s30
    v_xor_b32 v14, s33, v12
    buffer_load_dwordx4 v14, s[16:19], 0 offen nt lds
    s_waitcnt vmcnt(22)
    s_cbranch_vccz L_w10
    s_waitcnt vmcnt(20)
L_w10:
    s_add_u32 m0, s31, 33792
    s_xor_b32 s33, s30, 264704
    v_xor_b32 v14, s33, v13
    buffer_load_dwordx4 v14, s[16:19], 0 offen nt lds
    s_waitcnt vmcnt(22)
    s_cbranch_vccz L_w11
    s_waitcnt vmcnt(20)
L_w11:
    s_add_u32 m0, s31, 34816
    s_xor_b32 s33, s30, 33024
    v_xor_b32 v14, s33, v12
    buffer_load_dwordx4 v14, s[16:19], 0 offen nt lds
    s_waitcnt vmcnt(22)
    s_cbranch_vccz L_w12
    s_waitcnt vmcnt(20)
L_w12:
    s_add_u32 m0, s31, 35840
    s_xor_b32 s33, s30, 297728
    v_xor_b32 v14, s33, v13
    buffer_load_dwordx4 v14, s[16:19], 0 offen nt lds
    s_waitcnt vmcnt(22)
    s_cbranch_vccz L_w13
    s_waitcnt vmcnt(20)
L_w13:
    s_add_u32 m0, s31, 36864
    s_xor_b32 s33, s30, 16384
    v_xor_b32 v14, s33, v12
    buffer_load_dwordx4 v14, s[16:19], 0 offen nt lds
    s_waitcnt vmcnt(22)
    s_cbranch_vccz L_w14
    s_waitcnt vmcnt(20)
L_w14:
    s_add_u32 m0, s31, 37888
    s_xor_b32 s33, s30, 281088
    v_xor_b32 v14, s33, v13
    buffer_load_dwordx4 v14, s[16:19], 0 offen nt lds
    s_waitcnt vmcnt(22)
    s_cbranch_vccz L_w15
    s_waitcnt vmcnt(20)
L_w15:
    s_add_u32 m0, s31, 38912
    s_xor_b32 s33, s30, 49408
    v_xor_b32 v14, s33, v12
    buffer_load_dwordx4 v14, s[16:19], 0 offen nt lds
    s_waitcnt vmcnt(22)
    s_cbranch_vccz L_w16
    s_waitcnt vmcnt(20)
L_w16:
    s_add_u32 m0, s31, 39936
    s_xor_b32 s33, s30, 314112
    v_xor_b32 v14, s33, v13
    buffer_load_dwordx4 v14, s[16:19], 0 offen nt lds
    s_waitcnt vmcnt(22)
    s_cbranch_vccz L_w17
    s_waitcnt vmcnt(20)
L_w17:
    s_add_u32 m0, s31, 40960
    s_xor_b32 s33, s30, 4352
    v_xor_b32 v14, s33, v12
    buffer_load_dwordx4 v14, s[16:19], 0 offen nt lds
    s_waitcnt vmcnt(22)
    s_cbranch_vccz L_w18
    s_waitcnt vmcnt(20)
L_w18:
    s_add_u32 m0, s31, 41984
    s_xor_b32 s33, s30, 269056
    v_xor_b32 v14, s33, v13
    buffer_load_dwordx4 v14, s[16:19], 0 offen nt lds
    s_waitcnt vmcnt(22)
    s_cbranch_vccz L_w19
    s_waitcnt vmcnt(20)
L_w19:
    s_add_u32 m0, s31, 43008
    s_xor_b32 s33, s30, 36864
    v_xor_b32 v14, s33, v12
    buffer_load_dwordx4 v14, s[16:19], 0 offen nt lds
    s_waitcnt vmcnt(22)
    s_cbranch_vccz L_w20
    s_waitcnt vmcnt(20)
L_w20:
    s_add_u32 m0, s31, 44032
    s_xor_b32 s33, s30, 301568
    v_xor_b32 v14, s33, v13
    buffer_load_dwordx4 v14, s[16:19], 0 offen nt lds
    s_waitcnt vmcnt(22)
    s_cbranch_vccz L_w21
    s_waitcnt vmcnt(20)
L_w21:
    s_add_u32 m0, s31, 45056
    s_xor_b32 s33, s30, 20736
    v_xor_b32 v14, s33, v12
    buffer_load_dwordx4 v14, s[16:19], 0 offen nt lds
    s_waitcnt vmcnt(22)
    s_cbranch_vccz L_w22
    s_waitcnt vmcnt(20)
L_w22:
    s_add_u32 m0, s31, 46080
    s_xor_b32 s33, s30, 285440
    v_xor_b32 v14, s33, v13
    buffer_load_dwordx4 v14, s[16:19], 0 offen nt lds
    s_waitcnt vmcnt(22)
    s_cbranch_vccz L_w23
    s_waitcnt vmcnt(20)
L_w23:
    s_add_u32 m0, s31, 47104
    s_xor_b32 s33, s30, 53248
    v_xor_b32 v14, s33, v12
    buffer_load_dwordx4 v14, s[16:19], 0 offen nt lds
    s_waitcnt vmcnt(22)
    s_cbranch_vccz L_w24
    s_waitcnt vmcnt(20)
L_w24:
    s_add_u32 m0, s31, 48128
    s_xor_b32 s33, s30, 317952
    v_xor_b32 v14, s33, v13
    buffer_load_dwordx4 v14, s[16:19], 0 offen nt lds
    s_waitcnt vmcnt(22)
    s_cbranch_vccz L_w25
    s_waitcnt vmcnt(20)
L_w25:
    s_add_u32 m0, s31, 49152
    s_xor_b32 s33, s30, 37120
    v_xor_b32 v14, s33, v12
    buffer_load_dwordx4 v14, s[16:19], 0 offen nt lds
    s_waitcnt vmcnt(22)
    s_cbranch_vccz L_w26
    s_waitcnt vmcnt(20)
L_w26:
    s_add_u32 m0, s31, 50176
    s_xor_b32 s33, s30, 301824
    v_xor_b32 v14, s33, v13
    buffer_load_dwordx4 v14, s[16:19], 0 offen nt lds
    s_waitcnt vmcnt(22)
    s_cbranch_vccz L_w27
    s_waitcnt vmcnt(20)
L_w27:
    s_add_u32 m0, s31, 51200
    s_xor_b32 s33, s30, 4096
    v_xor_b32 v14, s33, v12
    buffer_load_dwordx4 v14, s[16:19], 0 offen nt lds
    s_waitcnt vmcnt(22)
    s_cbranch_vccz L_w28
    s_waitcnt vmcnt(20)
L_w28:
    s_add_u32 m0, s31, 52224
    s_xor_b32 s33, s30, 268800
    v_xor_b32 v14, s33, v13
    buffer_load_dwordx4 v14, s[16:19], 0 offen nt lds
    s_waitcnt vmcnt(22)
    s_cbranch_vccz L_w29
    s_waitcnt vmcnt(20)
L_w29:
    s_add_u32 m0, s31, 53248
    s_xor_b32 s33, s30, 53504
    v_xor_b32 v14, s33, v12
    buffer_load_dwordx4 v14, s[16:19], 0 offen nt lds
    s_waitcnt vmcnt(22)
    s_cbranch_vccz L_w30
    s_waitcnt vmcnt(20)
L_w30:
    s_add_u32 m0, s31, 54272
    s_xor_b32 s33, s30, 318208
    v_xor_b32 v14, s33, v13
    buffer_load_dwordx4 v14, s[16:19], 0 offen nt lds
    s_waitcnt vmcnt(22)
    s_barrier
    s_cbranch_vccz L_w31
    s_waitcnt vmcnt(20)
L_w31:
    s_add_u32 m0, s31, 55296
    s_xor_b32 s33, s30, 20480
    v_xor_b32 v14, s33, v12
    buffer_load_dwordx4 v14, s[16:19], 0 offen nt lds
    s_waitcnt vmcnt(22)
    s_cbranch_vccz L_w32
    s_waitcnt vmcnt(20)
L_w32:
    s_add_u32 m0, s31, 56320
    s_xor_b32 s33, s30, 285184
    v_xor_b32 v14, s33, v13
    buffer_load_dwordx4 v14, s[16:19], 0 offen nt lds
    s_waitcnt vmcnt(22)
    s_cbranch_vccz L_w33
    s_waitcnt vmcnt(20)
L_w33:
    s_add_u32 m0, s31, 57344
    s_xor_b32 s33, s30, 32768
    v_xor_b32 v14, s33, v12
    buffer_load_dwordx4 v14, s[16:19], 0 offen nt lds
    s_waitcnt vmcnt(22)
    s_cbranch_vccz L_w34
    s_waitcnt vmcnt(20)
L_w34:
    s_add_u32 m0, s31, 58368
    s_xor_b32 s33, s30, 297472
    v_xor_b32 v14, s33, v13
    buffer_load_dwordx4 v14, s[16:19], 0 offen nt lds
    s_waitcnt vmcnt(22)
    s_cbranch_vccz L_w35
    s_waitcnt vmcnt(20)
L_w35:
    s_add_u32 m0, s31, 59392
    s_xor_b32 s33, s30, 256
    v_xor_b32 v14, s33, v12
    buffer_load_dwordx4 v14, s[16:19], 0 offen nt lds
    s_waitcnt vmcnt(22)
    s_cbranch_vccz L_w36
    s_waitcnt vmcnt(20)
L_w36:
    s_add_u32 m0, s31, 60416
    s_xor_b32 s33, s30, 264960
    v_xor_b32 v14, s33, v13
    buffer_load_dwordx4 v14, s[16:19], 0 offen nt lds
    s_waitcnt vmcnt(22)
    s_cbranch_vccz L_w37
    s_waitcnt vmcnt(20)
L_w37:
    s_add_u32 m0, s31, 61440
    s_xor_b32 s33, s30, 49152
    v_xor_b32 v14, s33, v12
    buffer_load_dwordx4 v14, s[16:19], 0 offen nt lds
    s_waitcnt vmcnt(22)
    s_cbranch_vccz L_w38
    s_waitcnt vmcnt(20)
L_w38:
    s_add_u32 m0, s31, 62464
    s_xor_b32 s33, s30, 313856
    v_xor_b32 v14, s33, v13
    buffer_load_dwordx4 v14, s[16:19], 0 offen nt lds
    s_waitcnt vmcnt(22)
    s_cbranch_vccz L_w39
    s_waitcnt vmcnt(20)
L_w39:
    s_add_u32 m0, s31, 63488
    s_xor_b32 s33, s30, 16640
    v_xor_b32 v14, s33, v12
    buffer_load_dwordx4 v14, s[16:19], 0 offen nt lds
    s_waitcnt vmcnt(22)
    s_cbranch_vccz L_w40
    s_waitcnt vmcnt(20)
L_w40:
    s_add_u32 m0, s31, 64512
    s_xor_b32 s33, s30, 281344
    v_xor_b32 v14, s33, v13
    buffer_load_dwordx4 v14, s[16:19], 0 offen nt lds
    s_waitcnt vmcnt(22)
    ds_read_b32 v15, v16
    s_cbranch_vccz L_w41
    s_waitcnt vmcnt(20)
L_w41:
    s_mov_b32 m0, s32
    s_mov_b32 s33, s37
    v_xor_b32 v14, s33, v8
    buffer_load_dwordx4 v14, s[12:15], 0 offen nt lds
    s_waitcnt vmcnt(22)
    s_cbranch_vccz L_w42
    s_waitcnt vmcnt(20)
L_w42:
    s_add_u32 m0, s32, 1024
    s_xor_b32 s33, s37, 264704
    v_xor_b32 v14, s33, v9
    buffer_load_dwordx4 v14, s[12:15], 0 offen nt lds
    s_waitcnt vmcnt(22)
    s_cbranch_vccz L_w43
    s_waitcnt vmcnt(20)
L_w43:
    s_add_u32 m0, s32, 2048
    s_xor_b32 s33, s37, 33024
    v_xor_b32 v14, s33, v10
    buffer_load_dwordx4 v14, s[12:15], 0 offen nt lds
    s_waitcnt vmcnt(22)
    s_waitcnt lgkmcnt(0)
    v_readfirstlane_b32 s61, v15
    s_nop 1
    s_cmp_lg_u32 s61, 0
    s_cselect_b64 vcc, -1, 0
    s_cbranch_vccz L_w44
    s_waitcnt vmcnt(20)
L_w44:
    s_add_u32 m0, s32, 3072
    s_xor_b32 s33, s37, 297728
    v_xor_b32 v14, s33, v11
    buffer_load_dwordx4 v14, s[12:15], 0 offen nt lds
    s_waitcnt vmcnt(22)
    s_cbranch_vccz L_w45
    s_waitcnt vmcnt(20)
L_w45:
    s_add_u32 m0, s32, 4096
    s_xor_b32 s33, s37, 16384
    v_xor_b32 v14, s33, v8
    buffer_load_dwordx4 v14, s[12:15], 0 offen nt lds
    s_waitcnt vmcnt(22)
    s_cbranch_vccz L_w46
    s_waitcnt vmcnt(20)
L_w46:
    s_add_u32 m0, s32, 5120
    s_xor_b32 s33, s37, 281088
    v_xor_b32 v14, s33, v9
    buffer_load_dwordx4 v14, s[12:15], 0 offen nt lds
    s_waitcnt vmcnt(22)
    s_cbranch_vccz L_w47
    s_waitcnt vmcnt(20)
L_w47:
    s_add_u32 m0, s32, 6144
    s_xor_b32 s33, s37, 49408
    v_xor_b32 v14, s33, v10
    buffer_load_dwordx4 v14, s[12:15], 0 offen nt lds
    s_waitcnt vmcnt(22)
    s_cbranch_vccz L_w48
    s_waitcnt vmcnt(20)
L_w48:
    s_add_u32 m0, s32, 7168
    s_xor_b32 s33, s37, 314112
    v_xor_b32 v14, s33, v11
    buffer_load_dwordx4 v14, s[12:15], 0 offen nt lds
    s_waitcnt vmcnt(22)
    s_cbranch_vccz L_w49
    s_waitcnt vmcnt(20)
L_w49:
    s_add_u32 m0, s32, 8192
    s_xor_b32 s33, s37, 4352
    v_xor_b32 v14, s33, v8
    buffer_load_dwordx4 v14, s[12:15], 0 offen nt lds
    s_waitcnt vmcnt(22)
    s_cbranch_vccz L_w50
    s_waitcnt vmcnt(20)
L_w50:
    s_add_u32 m0, s32, 9216
    s_xor_b32 s33, s37, 269056
    v_xor_b32 v14, s33, v9
    buffer_load_dwordx4 v14, s[12:15], 0 offen nt lds
    s_waitcnt vmcnt(22)
    s_cbranch_vccz L_w51
    s_waitcnt vmcnt(20)
L_w51:
    s_add_u32 m0, s32, 10240
    s_xor_b32 s33, s37, 36864
    v_xor_b32 v14, s33, v10
    buffer_load_dwordx4 v14, s[12:15], 0 offen nt lds
    s_waitcnt vmcnt(22)
    s_cbranch_vccz L_w52
    s_waitcnt vmcnt(20)
L_w52:
    s_add_u32 m0, s32, 11264
    s_xor_b32 s33, s37, 301568
    v_xor_b32 v14, s33, v11
    buffer_load_dwordx4 v14, s[12:15], 0 offen nt lds
    s_waitcnt vmcnt(22)
    s_cbranch_vccz L_w53
    s_waitcnt vmcnt(20)
L_w53:
    s_add_u32 m0, s32, 12288
    s_xor_b32 s33, s37, 20736
    v_xor_b32 v14, s33, v8
    buffer_load_dwordx4 v14, s[12:15], 0 offen nt lds
    s_waitcnt vmcnt(22)
    s_cbranch_vccz L_w54
    s_waitcnt vmcnt(20)
L_w54:
    s_add_u32 m0, s32, 13312
    s_xor_b32 s33, s37, 285440
    v_xor_b32 v14, s33, v9
    buffer_load_dwordx4 v14, s[12:15], 0 offen nt lds
    s_waitcnt vmcnt(22)
    s_barrier
    s_cbranch_vccz L_w55
    s_waitcnt vmcnt(20)
L_w55:
    s_add_u32 m0, s32, 14336
    s_xor_b32 s33, s37, 53248
    v_xor_b32 v14, s33, v10
    buffer_load_dwordx4 v14, s[12:15], 0 offen nt lds
    s_waitcnt vmcnt(22)
    s_cbranch_vccz L_w56
    s_waitcnt vmcnt(20)
L_w56:
    s_add_u32 m0, s32, 15360
    s_xor_b32 s33, s37, 317952
    v_xor_b32 v14, s33, v11
    buffer_load_dwordx4 v14, s[12:15], 0 offen nt lds
    s_waitcnt vmcnt(22)
    s_cbranch_vccz L_w57
    s_waitcnt vmcnt(20)
L_w57:
    s_add_u32 m0, s32, 16384
    s_xor_b32 s33, s37, 37120
    v_xor_b32 v14, s33, v8
    buffer_load_dwordx4 v14, s[12:15], 0 offen nt lds
    s_waitcnt vmcnt(22)
    s_cbranch_vccz L_w58
    s_waitcnt vmcnt(20)
L_w58:
    s_add_u32 m0, s32, 17408
    s_xor_b32 s33, s37, 301824
    v_xor_b32 v14, s33, v9
    buffer_load_dwordx4 v14, s[12:15], 0 offen nt lds
    s_waitcnt vmcnt(22)
    s_cbranch_vccz L_w59
    s_waitcnt vmcnt(20)
L_w59:
    s_add_u32 m0, s32, 18432
    s_xor_b32 s33, s37, 4096
    v_xor_b32 v14, s33, v10
    buffer_load_dwordx4 v14, s[12:15], 0 offen nt lds
    s_waitcnt vmcnt(22)
    s_cbranch_vccz L_w60
    s_waitcnt vmcnt(20)
L_w60:
    s_add_u32 m0, s32, 19456
    s_xor_b32 s33, s37, 268800
    v_xor_b32 v14, s33, v11
    buffer_load_dwordx4 v14, s[12:15], 0 offen nt lds
    s_waitcnt vmcnt(22)
    s_cbranch_vccz L_w61
    s_waitcnt vmcnt(20)
L_w61:
    s_add_u32 m0, s32, 20480
    s_xor_b32 s33, s37, 53504
    v_xor_b32 v14, s33, v8
    buffer_load_dwordx4 v14, s[12:15], 0 offen nt lds
    s_waitcnt vmcnt(22)
    s_cbranch_vccz L_w62
    s_waitcnt vmcnt(20)
L_w62:
    s_add_u32 m0, s32, 21504
    s_xor_b32 s33, s37, 318208
    v_xor_b32 v14, s33, v9
    buffer_load_dwordx4 v14, s[12:15], 0 offen nt lds
    s_waitcnt vmcnt(22)
    s_barrier
    s_cbranch_vccz L_w63
    s_waitcnt vmcnt(20)
L_w63:
    s_add_u32 m0, s32, 22528
    s_xor_b32 s33, s37, 20480
    v_xor_b32 v14, s33, v10
    buffer_load_dwordx4 v14, s[12:15], 0 offen nt lds
    s_add_u32 s29, s29, 1
    s_mov_b32 s30, s37
    s_add_u32 s61, s29, 1
    s_mov_b32 s37, s60
    s_bitcmp1_b32 s61, 0
    s_cselect_b32 s62, 264192, 0
    s_xor_b32 s37, s37, s62
    s_bitcmp1_b32 s61, 1
    s_cselect_b32 s62, 140288, 0
    s_xor_b32 s37, s37, s62
    s_bitcmp1_b32 s61, 2
    s_cselect_b32 s62, 34048, 0
    s_xor_b32 s37, s37, s62
    s_bitcmp1_b32 s61, 3
    s_cselect_b32 s62, 3072, 0
    s_xor_b32 s37, s37, s62
    s_lshr_b32 s62, s61, 4
    s_lshl_b32 s62, s62, 19
    s_or_b32 s37, s37, s62
    s_xor_b32 s31, s31, 0x10000
    s_xor_b32 s32, s32, 0x10000
    s_cmp_lt_u32 s29, 16
    s_cbranch_scc1 L_ldloop
    s_waitcnt vmcnt(0)
    s_endpgm
.p2align 6
L_consumer:
    s_sub_u32 s28, s28, 1
    v_lshlrev_b32 v12, 8, v3
    s_and_b32 s33, s28, 1
    v_lshl_add_u32 v12, v4, 4, v12
    s_lshl_b32 s36, s33, 7
    s_lshl_b32 s29, s28, 11
    v_xor_b32 v12, s36, v12
    s_add_u32 m0, s29, 131072
    v_xor_b32 v13, 64, v12
    s_mov_b32 s22, 0x2000
    s_mov_b32 s23, 0x20000
    s_lshl_b32 s34, s2, 13
    s_waitcnt lgkmcnt(0)
    s_add_u32 s20, s4, s34
    s_addc_u32 s21, s5, 0
    s_add_u32 s24, s10, s34
    s_addc_u32 s25, s11, 0
    buffer_load_dwordx4 v12, s[20:23], s29 offen lds
    buffer_load_dwordx4 v13, s[20:23], s29 offen offset:1024 lds
    s_mov_b32 s26, 0x2000
    s_mov_b32 s27, 0x20000
    v_lshlrev_b32 v14, 8, v2
    v_lshl_add_u32 v4, v4, 4, v14
    v_xor_b32 v5, 64, v4
    v_xor_b32 v6, 128, v4
    v_xor_b32 v7, 192, v4
    v_bfe_u32 v15, v0, 2, 2
    v_lshl_add_u32 v16, v3, 2, v15
    v_and_b32 v17, 7, v16
    s_lshl_b32 s36, s33, 2
    v_xor_b32 v17, s36, v17
    v_lshlrev_b32 v16, 8, v16
    v_lshl_add_u32 v16, v17, 5, v16
    v_and_b32 v15, 3, v0
    v_lshl_add_u32 v8, v15, 3, v16
    v_xor_b32 v9, 32, v8
    v_xor_b32 v10, 64, v8
    v_xor_b32 v11, 96, v8
    s_lshr_b32 s36, s28, 1
    s_lshl_b32 s36, s36, 12
    s_lshl_b32 s33, s33, 7
    s_add_u32 s33, s33, s36
    v_and_b32 v15, 1, v3
    v_lshl_add_u32 v14, v15, 5, v14
    v_lshrrev_b32 v15, 1, v3
    v_lshl_add_u32 v14, v15, 4, v14
    v_add_u32 v22, s33, v14
    s_add_u32 s36, s36, 131072
    v_add_u32 v12, s36, v4
    v_add_u32 v13, s36, v5
    v_add_u32 v14, s36, v6
    v_add_u32 v15, s36, v7
    v_mov_b32 v96, 0
    v_mov_b32 v97, 0
    v_mov_b32 v98, 0
    v_mov_b32 v99, 0
    v_mov_b32 v100, 0
    v_mov_b32 v101, 0
    v_mov_b32 v102, 0
    v_mov_b32 v103, 0
    v_mov_b32 v104, 0
    v_mov_b32 v105, 0
    v_mov_b32 v106, 0
    v_mov_b32 v107, 0
    v_mov_b32 v108, 0
    v_mov_b32 v109, 0
    v_mov_b32 v110, 0
    v_mov_b32 v111, 0
    v_mov_b32 v28, 0
    v_mov_b32 v24, 0x3f803f80
    v_mov_b32 v29, 0
    v_mov_b32 v25, 0x3f803f80
    v_mov_b32 v30, 0
    v_mov_b32 v26, 0x3f803f80
    v_mov_b32 v31, 0
    v_mov_b32 v27, 0x3f803f80
    v_mov_b32 v16, 0xff800000
    v_mov_b32 v17, 0
    v_mov_b32 v19, 0
    v_mov_b32 v21, 0
    s_mov_b32 s34, 0x3e0293ee
    s_mov_b32 s35, s34
    s_mov_b32 s29, 0
    s_getreg_b32 s36, hwreg(HW_REG_XCC_ID, 0, 3)
    s_lshl_b32 s36, s36, 5
    v_and_b32 v176, 31, v0
    v_lshl_add_u32 v176, v176, 0, s36
    s_bfe_u32 s61, s2, 0x50003
    s_add_u32 s61, s61, s36
    v_mov_b32 v177, s61
    v_mov_b32 v1, 139264
    v_mov_b32 v23, 1
    ds_write_b32 v1, v23
    s_mov_b32 s57, 27
    s_mov_b32 s55, 0
    s_waitcnt lgkmcnt(0)
    s_waitcnt vmcnt(0)
    s_barrier
    ds_read_b128 v[32:35], v12
    ds_read_b128 v[36:39], v13
    ds_read_b128 v[40:43], v14
    ds_read_b128 v[44:47], v15
    s_branch L_kready
.p2align 6
L_cloop:
    s_barrier
L_kready:
    s_cmp_eq_u32 s55, 0
    s_cbranch_scc1 L_noeval
    s_getreg_b32 s61, hwreg(HW_REG_IB_STS, 0, 4)
    s_cmp_lg_u32 s61, 0
    s_cbranch_scc1 L_noeval
    s_waitcnt vmcnt(0)
    v_subrev_u32 v12, s55, v178
    v_cmp_gt_u32 vcc, 8, v12
    s_mov_b32 s55, 0
    s_nop 0
    s_bcnt1_i32_b32 s61, vcc_lo
    s_cmp_lt_u32 s61, s57
    s_cselect_b32 s61, 1, 0
    v_mov_b32 v12, s61
    ds_write_b32 v1, v12
L_noeval:
    ds_read_b128 v[112:115], v4
    ds_read_b128 v[116:119], v5
    ds_read_b128 v[120:123], v6
    ds_read_b128 v[124:127], v7
    ds_read_b128 v[128:131], v4 offset:4096
    ds_read_b128 v[132:135], v5 offset:4096
    ds_read_b128 v[136:139], v6 offset:4096
    ds_read_b128 v[140:143], v7 offset:4096
    ds_read_b128 v[144:147], v4 offset:8192
    ds_read_b128 v[148:151], v5 offset:8192
    ds_read_b128 v[152:155], v6 offset:8192
    ds_read_b128 v[156:159], v7 offset:8192
    s_waitcnt lgkmcnt(8)
    v_mfma_f32_16x16x32_bf16 v[48:51], v[112:115], v[32:35], 0
    v_mfma_f32_16x16x32_bf16 v[48:51], v[116:119], v[36:39], v[48:51]
    v_mfma_f32_16x16x32_bf16 v[48:51], v[120:123], v[40:43], v[48:51]
    v_mfma_f32_16x16x32_bf16 v[48:51], v[124:127], v[44:47], v[48:51]
    ds_read_b128 v[160:163], v4 offset:12288
    ds_read_b128 v[164:167], v5 offset:12288
    ds_read_b128 v[168:171], v6 offset:12288
    ds_read_b128 v[172:175], v7 offset:12288
    s_waitcnt lgkmcnt(8)
    v_mfma_f32_16x16x32_bf16 v[52:55], v[128:131], v[32:35], 0
    v_mfma_f32_16x16x32_bf16 v[52:55], v[132:135], v[36:39], v[52:55]
    v_mfma_f32_16x16x32_bf16 v[52:55], v[136:139], v[40:43], v[52:55]
    v_mfma_f32_16x16x32_bf16 v[52:55], v[140:143], v[44:47], v[52:55]
    ds_read_b128 v[112:115], v4 offset:16384
    ds_read_b128 v[116:119], v5 offset:16384
    ds_read_b128 v[120:123], v6 offset:16384
    ds_read_b128 v[124:127], v7 offset:16384
    s_waitcnt lgkmcnt(8)
    v_mfma_f32_16x16x32_bf16 v[56:59], v[144:147], v[32:35], 0
    v_mfma_f32_16x16x32_bf16 v[56:59], v[148:151], v[36:39], v[56:59]
    v_mfma_f32_16x16x32_bf16 v[56:59], v[152:155], v[40:43], v[56:59]
    v_mfma_f32_16x16x32_bf16 v[56:59], v[156:159], v[44:47], v[56:59]
    ds_read_b128 v[128:131], v4 offset:20480
    ds_read_b128 v[132:135], v5 offset:20480
    ds_read_b128 v[136:139], v6 offset:20480
    ds_read_b128 v[140:143], v7 offset:20480
    v_max_f32 v12, v48, v49
    v_max_f32 v13, v50, v51
    s_waitcnt lgkmcnt(8)
    v_mfma_f32_16x16x32_bf16 v[60:63], v[160:163], v[32:35], 0
    v_mfma_f32_16x16x32_bf16 v[60:63], v[164:167], v[36:39], v[60:63]
    v_mfma_f32_16x16x32_bf16 v[60:63], v[168:171], v[40:43], v[60:63]
    v_mfma_f32_16x16x32_bf16 v[60:63], v[172:175], v[44:47], v[60:63]
    ds_read_b128 v[144:147], v4 offset:24576
    ds_read_b128 v[148:151], v5 offset:24576
    ds_read_b128 v[152:155], v6 offset:24576
    ds_read_b128 v[156:159], v7 offset:24576
    v_max3_f32 v12, v12, v52, v53
    v_max3_f32 v13, v13, v54, v55
    s_waitcnt lgkmcnt(8)
    v_mfma_f32_16x16x32_bf16 v[64:67], v[112:115], v[32:35], 0
    v_mfma_f32_16x16x32_bf16 v[64:67], v[116:119], v[36:39], v[64:67]
    v_mfma_f32_16x16x32_bf16 v[64:67], v[120:123], v[40:43], v[64:67]
    v_mfma_f32_16x16x32_bf16 v[64:67], v[124:127], v[44:47], v[64:67]
    ds_read_b128 v[160:163], v4 offset:28672
    ds_read_b128 v[164:167], v5 offset:28672
    ds_read_b128 v[168:171], v6 offset:28672
    ds_read_b128 v[172:175], v7 offset:28672
    v_max3_f32 v12, v12, v56, v57
    v_max3_f32 v13, v13, v58, v59
    s_waitcnt lgkmcnt(8)
    v_mfma_f32_16x16x32_bf16 v[68:71], v[128:131], v[32:35], 0
    v_mfma_f32_16x16x32_bf16 v[68:71], v[132:135], v[36:39], v[68:71]
    v_mfma_f32_16x16x32_bf16 v[68:71], v[136:139], v[40:43], v[68:71]
    v_mfma_f32_16x16x32_bf16 v[68:71], v[140:143], v[44:47], v[68:71]
    v_max3_f32 v12, v12, v60, v61
    v_max3_f32 v13, v13, v62, v63
    s_waitcnt lgkmcnt(4)
    v_mfma_f32_16x16x32_bf16 v[72:75], v[144:147], v[32:35], 0
    v_mfma_f32_16x16x32_bf16 v[72:75], v[148:151], v[36:39], v[72:75]
    v_mfma_f32_16x16x32_bf16 v[72:75], v[152:155], v[40:43], v[72:75]
    v_mfma_f32_16x16x32_bf16 v[72:75], v[156:159], v[44:47], v[72:75]
    v_max3_f32 v12, v12, v64, v65
    v_max3_f32 v13, v13, v66, v67
    s_waitcnt lgkmcnt(0)
    v_mfma_f32_16x16x32_bf16 v[76:79], v[160:163], v[32:35], 0
    v_mfma_f32_16x16x32_bf16 v[76:79], v[164:167], v[36:39], v[76:79]
    v_mfma_f32_16x16x32_bf16 v[76:79], v[168:171], v[40:43], v[76:79]
    v_mfma_f32_16x16x32_bf16 v[76:79], v[172:175], v[44:47], v[76:79]
    v_max3_f32 v12, v12, v68, v69
    v_max3_f32 v13, v13, v70, v71
    v_xor_b32 v4, 0x10000, v4
    v_xor_b32 v5, 0x10000, v5
    v_xor_b32 v6, 0x10000, v6
    v_xor_b32 v7, 0x10000, v7
    v_max3_f32 v12, v12, v72, v73
    v_max3_f32 v13, v13, v74, v75
    s_nop 0
    v_max3_f32 v12, v12, v76, v77
    v_max3_f32 v13, v13, v78, v79
    v_max_f32 v14, v12, v13
    v_max_f32 v15, v12, v13
    s_nop 1
    v_permlane16_swap_b32 v14, v15
    v_max_f32 v12, v14, v15
    v_max_f32 v13, v14, v15
    s_nop 1
    v_permlane32_swap_b32 v12, v13
    v_max_f32 v12, v12, v13
    v_mul_f32 v12, s34, v12
    v_mov_b32 v13, v16
    v_max_f32 v16, v12, v16
    v_sub_f32 v13, v13, v16
    v_exp_f32 v18, v13
    v_pk_fma_f32 v[48:49], v[48:49], s[34:35], v[16:17] op_sel_hi:[1,0,0] neg_lo:[0,0,1] neg_hi:[0,0,1]
    v_pk_fma_f32 v[50:51], v[50:51], s[34:35], v[16:17] op_sel_hi:[1,0,0] neg_lo:[0,0,1] neg_hi:[0,0,1]
    v_pk_fma_f32 v[52:53], v[52:53], s[34:35], v[16:17] op_sel_hi:[1,0,0] neg_lo:[0,0,1] neg_hi:[0,0,1]
    v_pk_fma_f32 v[54:55], v[54:55], s[34:35], v[16:17] op_sel_hi:[1,0,0] neg_lo:[0,0,1] neg_hi:[0,0,1]
    v_pk_fma_f32 v[56:57], v[56:57], s[34:35], v[16:17] op_sel_hi:[1,0,0] neg_lo:[0,0,1] neg_hi:[0,0,1]
    v_pk_fma_f32 v[58:59], v[58:59], s[34:35], v[16:17] op_sel_hi:[1,0,0] neg_lo:[0,0,1] neg_hi:[0,0,1]
    v_pk_fma_f32 v[60:61], v[60:61], s[34:35], v[16:17] op_sel_hi:[1,0,0] neg_lo:[0,0,1] neg_hi:[0,0,1]
    v_pk_fma_f32 v[62:63], v[62:63], s[34:35], v[16:17] op_sel_hi:[1,0,0] neg_lo:[0,0,1] neg_hi:[0,0,1]
    v_pk_fma_f32 v[64:65], v[64:65], s[34:35], v[16:17] op_sel_hi:[1,0,0] neg_lo:[0,0,1] neg_hi:[0,0,1]
    v_pk_fma_f32 v[66:67], v[66:67], s[34:35], v[16:17] op_sel_hi:[1,0,0] neg_lo:[0,0,1] neg_hi:[0,0,1]
    v_pk_fma_f32 v[68:69], v[68:69], s[34:35], v[16:17] op_sel_hi:[1,0,0] neg_lo:[0,0,1] neg_hi:[0,0,1]
    v_pk_fma_f32 v[70:71], v[70:71], s[34:35], v[16:17] op_sel_hi:[1,0,0] neg_lo:[0,0,1] neg_hi:[0,0,1]
    v_pk_fma_f32 v[72:73], v[72:73], s[34:35], v[16:17] op_sel_hi:[1,0,0] neg_lo:[0,0,1] neg_hi:[0,0,1]
    v_pk_fma_f32 v[74:75], v[74:75], s[34:35], v[16:17] op_sel_hi:[1,0,0] neg_lo:[0,0,1] neg_hi:[0,0,1]
    v_pk_fma_f32 v[76:77], v[76:77], s[34:35], v[16:17] op_sel_hi:[1,0,0] neg_lo:[0,0,1] neg_hi:[0,0,1]
    v_pk_fma_f32 v[78:79], v[78:79], s[34:35], v[16:17] op_sel_hi:[1,0,0] neg_lo:[0,0,1] neg_hi:[0,0,1]
    v_mul_f32 v28, v28, v18
    v_exp_f32 v48, v48
    v_exp_f32 v49, v49
    v_exp_f32 v50, v50
    v_exp_f32 v51, v51
    v_cvt_pk_bf16_f32 v80, v48, v49
    v_exp_f32 v52, v52
    v_exp_f32 v53, v53
    v_cvt_pk_bf16_f32 v81, v50, v51
    v_exp_f32 v54, v54
    v_exp_f32 v55, v55
    v_cvt_pk_bf16_f32 v82, v52, v53
    v_exp_f32 v56, v56
    v_exp_f32 v57, v57
    v_cvt_pk_bf16_f32 v83, v54, v55
    v_exp_f32 v58, v58
    v_exp_f32 v59, v59
    v_cvt_pk_bf16_f32 v84, v56, v57
    v_mfma_f32_16x16x32_bf16 v[28:31], v[24:27], v[80:83], v[28:31]
    v_exp_f32 v60, v60
    v_exp_f32 v61, v61
    v_cvt_pk_bf16_f32 v85, v58, v59
    v_exp_f32 v62, v62
    v_exp_f32 v63, v63
    v_cvt_pk_bf16_f32 v86, v60, v61
    v_exp_f32 v64, v64
    v_exp_f32 v65, v65
    v_cvt_pk_bf16_f32 v87, v62, v63
    v_exp_f32 v66, v66
    v_exp_f32 v67, v67
    v_cvt_pk_bf16_f32 v88, v64, v65
    v_mfma_f32_16x16x32_bf16 v[28:31], v[24:27], v[84:87], v[28:31]
    v_exp_f32 v68, v68
    v_exp_f32 v69, v69
    v_cvt_pk_bf16_f32 v89, v66, v67
    v_exp_f32 v70, v70
    v_exp_f32 v71, v71
    v_cvt_pk_bf16_f32 v90, v68, v69
    v_exp_f32 v72, v72
    v_exp_f32 v73, v73
    v_cvt_pk_bf16_f32 v91, v70, v71
    v_exp_f32 v74, v74
    v_exp_f32 v75, v75
    v_cvt_pk_bf16_f32 v92, v72, v73
    v_mfma_f32_16x16x32_bf16 v[28:31], v[24:27], v[88:91], v[28:31]
    v_exp_f32 v76, v76
    v_exp_f32 v77, v77
    v_cvt_pk_bf16_f32 v93, v74, v75
    v_exp_f32 v78, v78
    v_exp_f32 v79, v79
    v_cvt_pk_bf16_f32 v94, v76, v77
    v_pk_mul_f32 v[96:97], v[96:97], v[18:19] op_sel_hi:[1,0]
    v_cvt_pk_bf16_f32 v95, v78, v79
    v_pk_mul_f32 v[98:99], v[98:99], v[18:19] op_sel_hi:[1,0]
    v_pk_mul_f32 v[100:101], v[100:101], v[18:19] op_sel_hi:[1,0]
    v_pk_mul_f32 v[102:103], v[102:103], v[18:19] op_sel_hi:[1,0]
    v_pk_mul_f32 v[104:105], v[104:105], v[18:19] op_sel_hi:[1,0]
    v_pk_mul_f32 v[106:107], v[106:107], v[18:19] op_sel_hi:[1,0]
    v_pk_mul_f32 v[108:109], v[108:109], v[18:19] op_sel_hi:[1,0]
    v_pk_mul_f32 v[110:111], v[110:111], v[18:19] op_sel_hi:[1,0]
    v_mfma_f32_16x16x32_bf16 v[28:31], v[24:27], v[92:95], v[28:31]
    s_barrier
    ds_read_b64_tr_b16 v[112:113], v8 offset:32768
    ds_read_b64_tr_b16 v[114:115], v8 offset:36864
    ds_read_b64_tr_b16 v[116:117], v9 offset:32768
    ds_read_b64_tr_b16 v[118:119], v9 offset:36864
    ds_read_b64_tr_b16 v[120:121], v10 offset:32768
    ds_read_b64_tr_b16 v[122:123], v10 offset:36864
    ds_read_b64_tr_b16 v[124:125], v11 offset:32768
    ds_read_b64_tr_b16 v[126:127], v11 offset:36864
    ds_read_b64_tr_b16 v[128:129], v8 offset:40960
    ds_read_b64_tr_b16 v[130:131], v8 offset:45056
    ds_read_b64_tr_b16 v[132:133], v9 offset:40960
    ds_read_b64_tr_b16 v[134:135], v9 offset:45056
    ds_read_b64_tr_b16 v[136:137], v10 offset:40960
    ds_read_b64_tr_b16 v[138:139], v10 offset:45056
    v_rcp_f32 v20, v28
    s_waitcnt lgkmcnt(12)
    v_mfma_f32_16x16x32_bf16 v[96:99], v[112:115], v[80:83], v[96:99]
    ds_read_b64_tr_b16 v[140:141], v11 offset:40960
    ds_read_b64_tr_b16 v[142:143], v11 offset:45056
    s_waitcnt lgkmcnt(12)
    v_mfma_f32_16x16x32_bf16 v[100:103], v[116:119], v[80:83], v[100:103]
    ds_read_b64_tr_b16 v[144:145], v8 offset:49152
    ds_read_b64_tr_b16 v[146:147], v8 offset:53248
    s_waitcnt lgkmcnt(12)
    v_mfma_f32_16x16x32_bf16 v[104:107], v[120:123], v[80:83], v[104:107]
    ds_read_b64_tr_b16 v[148:149], v9 offset:49152
    ds_read_b64_tr_b16 v[150:151], v9 offset:53248
    s_waitcnt lgkmcnt(12)
    v_mfma_f32_16x16x32_bf16 v[108:111], v[124:127], v[80:83], v[108:111]
    ds_read_b64_tr_b16 v[152:153], v10 offset:49152
    ds_read_b64_tr_b16 v[154:155], v10 offset:53248
    s_waitcnt lgkmcnt(12)
    v_mfma_f32_16x16x32_bf16 v[96:99], v[128:131], v[84:87], v[96:99]
    ds_read_b64_tr_b16 v[156:157], v11 offset:49152
    ds_read_b64_tr_b16 v[158:159], v11 offset:53248
    s_waitcnt lgkmcnt(12)
    v_mfma_f32_16x16x32_bf16 v[100:103], v[132:135], v[84:87], v[100:103]
    s_waitcnt lgkmcnt(10)
    v_mfma_f32_16x16x32_bf16 v[104:107], v[136:139], v[84:87], v[104:107]
    s_waitcnt lgkmcnt(8)
    v_mfma_f32_16x16x32_bf16 v[108:111], v[140:143], v[84:87], v[108:111]
    s_waitcnt lgkmcnt(6)
    v_mfma_f32_16x16x32_bf16 v[96:99], v[144:147], v[88:91], v[96:99]
    s_waitcnt lgkmcnt(4)
    v_mfma_f32_16x16x32_bf16 v[100:103], v[148:151], v[88:91], v[100:103]
    s_waitcnt lgkmcnt(2)
    v_mfma_f32_16x16x32_bf16 v[104:107], v[152:155], v[88:91], v[104:107]
    s_waitcnt lgkmcnt(0)
    v_mfma_f32_16x16x32_bf16 v[108:111], v[156:159], v[88:91], v[108:111]
    s_barrier
    s_cmp_lg_u32 s28, 1
    s_cbranch_scc1 L_nopostv
    s_add_u32 s61, s29, 1
    s_cmp_gt_u32 s61, 15
    s_cbranch_scc1 L_nopostv
    s_mov_b64 exec, 1
    v_mov_b32 v23, s61
    global_store_byte v177, v23, s[58:59]
    s_mov_b64 exec, -1
L_nopostv:
    ds_read_b64_tr_b16 v[160:161], v8 offset:57344
    ds_read_b64_tr_b16 v[162:163], v8 offset:61440
    ds_read_b64_tr_b16 v[164:165], v9 offset:57344
    ds_read_b64_tr_b16 v[166:167], v9 offset:61440
    ds_read_b64_tr_b16 v[168:169], v10 offset:57344
    ds_read_b64_tr_b16 v[170:171], v10 offset:61440
    ds_read_b64_tr_b16 v[172:173], v11 offset:57344
    ds_read_b64_tr_b16 v[174:175], v11 offset:61440
    s_waitcnt lgkmcnt(6)
    v_mfma_f32_16x16x32_bf16 v[96:99], v[160:163], v[92:95], v[96:99]
    s_waitcnt lgkmcnt(4)
    v_mfma_f32_16x16x32_bf16 v[100:103], v[164:167], v[92:95], v[100:103]
    s_waitcnt lgkmcnt(2)
    v_mfma_f32_16x16x32_bf16 v[104:107], v[168:171], v[92:95], v[104:107]
    s_waitcnt lgkmcnt(0)
    v_mfma_f32_16x16x32_bf16 v[108:111], v[172:175], v[92:95], v[108:111]
    v_xor_b32 v8, 0x10000, v8
    v_xor_b32 v9, 0x10000, v9
    v_xor_b32 v10, 0x10000, v10
    v_xor_b32 v11, 0x10000, v11
    s_cmp_lg_u32 s28, 0
    s_cbranch_scc1 L_noiss
    s_cmp_ge_u32 s29, 15
    s_cbranch_scc1 L_noiss
    s_cmp_lg_u32 s55, 0
    s_cbranch_scc1 L_noiss
    global_load_ubyte v178, v176, s[58:59] sc1
    s_add_u32 s55, s29, 1
L_noiss:
    s_add_u32 s29, s29, 1
    s_cmp_lt_u32 s29, 16
    s_cbranch_scc1 L_cloop
    v_pk_mul_f32 v[96:97], v[96:97], v[20:21] op_sel_hi:[1,0]
    v_pk_mul_f32 v[98:99], v[98:99], v[20:21] op_sel_hi:[1,0]
    v_pk_mul_f32 v[100:101], v[100:101], v[20:21] op_sel_hi:[1,0]
    v_pk_mul_f32 v[102:103], v[102:103], v[20:21] op_sel_hi:[1,0]
    v_cvt_pk_bf16_f32 v80, v96, v97
    v_cvt_pk_bf16_f32 v81, v98, v99
    v_cvt_pk_bf16_f32 v82, v100, v101
    v_cvt_pk_bf16_f32 v83, v102, v103
    v_pk_mul_f32 v[104:105], v[104:105], v[20:21] op_sel_hi:[1,0]
    v_pk_mul_f32 v[106:107], v[106:107], v[20:21] op_sel_hi:[1,0]
    v_permlane16_swap_b32 v80, v82
    v_permlane16_swap_b32 v81, v83
    v_pk_mul_f32 v[108:109], v[108:109], v[20:21] op_sel_hi:[1,0]
    v_pk_mul_f32 v[110:111], v[110:111], v[20:21] op_sel_hi:[1,0]
    buffer_store_dwordx4 v[80:83], v22, s[24:27], 0 offen
    v_cvt_pk_bf16_f32 v84, v104, v105
    v_cvt_pk_bf16_f32 v85, v106, v107
    v_cvt_pk_bf16_f32 v86, v108, v109
    v_cvt_pk_bf16_f32 v87, v110, v111
    s_nop 1
    v_permlane16_swap_b32 v84, v86
    v_permlane16_swap_b32 v85, v87
    s_nop 0
    buffer_store_dwordx4 v[84:87], v22, s[24:27], 0 offen offset:64
L_end:
    s_endpgm
.section .rodata,"a"
.p2align 6
.amdhsa_kernel standalone__gqa_softmax__sampling_kernel
  .amdhsa_next_free_vgpr 184
  .amdhsa_next_free_sgpr 64
  .amdhsa_accum_offset 184
  .amdhsa_group_segment_fixed_size 0
  .amdhsa_kernarg_size 48
  .amdhsa_user_sgpr_count 2
  .amdhsa_user_sgpr_kernarg_segment_ptr 1
  .amdhsa_system_sgpr_workgroup_id_x 1
.end_amdhsa_kernel
```
